```python
import torch

def _softmax(x, axis=-1):
    return torch.softmax(x, dim=axis)

def _gelu(x):
    return torch.nn.functional.gelu(x, approximate='tanh')

def _silu(x):
    return torch.nn.functional.silu(x)

def _sigmoid(x):
    return torch.sigmoid(x)

def _layernorm(x, axis=-1, eps=1e-05):
    m = x.mean(dim=axis, keepdim=True)
    v = x.var(dim=axis, keepdim=True, unbiased=False)
    return (x - m) / torch.sqrt(v + eps)

def _scatter_add(tgt, idx, src, axis=0):
    return tgt.clone().index_add_(axis, idx, src)

def _segment_sum(src, seg, n):
    out = torch.zeros((n,) + src.shape[1:], dtype=src.dtype)
    return out.index_add_(0, seg, src)

def _pad(x, pw):
    flat = tuple((v for pair in reversed(pw) for v in pair))
    return torch.nn.functional.pad(x, flat)
kernel_name = 'standalone__kv_cache_quant_pre_rope_vs_post_rope__decode'

def setup_inputs():

    _w = lambda a: (lambda t: t.to(torch.bfloat16) if t.is_floating_point() else t)(torch.as_tensor(a))
    B, Sq, Skv = (2, 1, 4096)
    H, Dh0 = (32, 192)
    G = 128 if 128 > 0 else Dh0
    G = max(2, G // 2 * 2)
    Dh = max(G, Dh0 // G * G)
    Skv = max(Skv, Sq)
    ng = Dh // G
    bits = 8 if 8 > 1 else 4
    bits = max(2, min(8, bits))
    qmax = (1 << bits) - 1
    half = Dh // 2
    inv = 1.0 / 10000.0 ** (torch.arange(half) / max(1, half))
    ang_k = torch.arange(Skv)[:, None] * inv[None, :]
    ang_q = torch.arange(Skv - Sq, Skv)[:, None] * inv[None, :]
    kc = torch.cat([torch.cos(ang_k), torch.cos(ang_k)], dim=-1)
    ks = torch.cat([torch.sin(ang_k), torch.sin(ang_k)], dim=-1)
    qc = torch.cat([torch.cos(ang_q), torch.cos(ang_q)], dim=-1)
    qs = torch.cat([torch.sin(ang_q), torch.sin(ang_q)], dim=-1)
    qk_i = torch.randint(0, qmax + 1, (B, H, Skv, Dh)).to(torch.int32)
    qv_i = torch.randint(0, qmax + 1, (B, H, Skv, Dh)).to(torch.int32)
    ksc = torch.abs((lambda *s: torch.randn(*s, dtype=torch.bfloat16) * 0.05)(B, H, Skv, ng)) * 0.1 + 0.01
    kzp = torch.full((B, H, Skv, ng), qmax / 2.0)
    vsc = torch.abs((lambda *s: torch.randn(*s, dtype=torch.bfloat16) * 0.05)(B, H, Skv, ng)) * 0.1 + 0.01
    vzp = torch.full((B, H, Skv, ng), qmax / 2.0)
    return {'q': _w((lambda *s: torch.randn(*s, dtype=torch.bfloat16) * 0.8)(B, H, Sq, Dh) * 0.5), 'qk': _w(qk_i), 'k_scales': _w(ksc), 'k_zeros': _w(kzp), 'qv': _w(qv_i), 'v_scales': _w(vsc), 'v_zeros': _w(vzp), 'q_cos': _w(qc), 'q_sin': _w(qs), 'k_cos': _w(kc), 'k_sin': _w(ks)}

def reference(q, qk, k_scales, k_zeros, qv, v_scales, v_zeros, q_cos, q_sin, k_cos, k_sin):
    B, H, Sq, Dh = q.shape
    ng = k_scales.shape[-1]
    G = Dh // ng
    half = Dh // 2
    ks = (lambda x, n, axis: torch.repeat_interleave(x, n, dim=axis))(k_scales, G, axis=-1)
    kz = (lambda x, n, axis: torch.repeat_interleave(x, n, dim=axis))(k_zeros, G, axis=-1)
    k = ((lambda x, dt: x.to(dt))(qk, q.dtype) - kz) * ks
    vs = (lambda x, n, axis: torch.repeat_interleave(x, n, dim=axis))(v_scales, G, axis=-1)
    vz = (lambda x, n, axis: torch.repeat_interleave(x, n, dim=axis))(v_zeros, G, axis=-1)
    v = ((lambda x, dt: x.to(dt))(qv, q.dtype) - vz) * vs
    k1 = k[..., :half].clone()
    k2 = k[..., half:].clone()
    krh = torch.concatenate([-k2, k1], axis=-1)
    kr = k * k_cos[None, None, :, :] + krh * k_sin[None, None, :, :]
    q1 = q[..., :half].clone()
    q2 = q[..., half:].clone()
    qrh = torch.concatenate([-q2, q1], axis=-1)
    qr = q * q_cos[None, None, :, :] + qrh * q_sin[None, None, :, :]
    logits = torch.einsum('bhqd,bhkd->bhqk', qr, kr) * float(Dh) ** (-0.5)
    attn = _softmax(logits, axis=-1)
    out = torch.einsum('bhqk,bhkd->bhqd', attn, v)
    return out
```

```asm
; @launch grid=(256,1,1) block=(512,1,1) lds=91136
.amdgcn_target "amdgcn-amd-amdhsa--gfx950"
.text
.globl standalone__kv_cache_quant_pre_rope_vs_post_rope__decode_kernel
.p2align 8
.type standalone__kv_cache_quant_pre_rope_vs_post_rope__decode_kernel,@function
standalone__kv_cache_quant_pre_rope_vs_post_rope__decode_kernel:
s_cmp_ge_u32 s2, 256
s_cbranch_scc1 L_end
s_load_dwordx16 s[36:51], s[0:1], 0
s_load_dwordx8 s[52:59], s[0:1], 64
s_load_dwordx4 s[60:63], s[0:1], 96
v_lshrrev_b32 v1, 6, v0
v_and_b32 v0, 63, v0
v_readfirstlane_b32 s3, v1
s_and_b32 s34, s2, 7
s_lshr_b32 s66, s2, 3
s_and_b32 s33, s66, 3
s_lshr_b32 s32, s66, 2
s_and_b32 s64, s3, 3
s_lshr_b32 s65, s3, 2
s_mul_i32 s24, s3, 5
s_mul_i32 s66, s33, 3
s_add_u32 s24, s24, s66
s_mul_i32 s66, s34, 7
s_add_u32 s24, s24, s66
s_and_b32 s24, s24, 31
s_lshl_b32 s24, s24, 10
s_lshl_b32 s35, s34, 6
s_lshl_b32 s66, s33, 9
s_add_u32 s35, s35, s66
s_lshl_b32 s66, s65, 11
s_add_u32 s66, s66, s35
s_lshl_b32 s66, s66, 9
s_lshl_b32 s67, s32, 24
s_add_u32 s66, s66, s67
s_lshl_b32 s67, s64, 22
s_add_u32 s66, s66, s67
v_lshlrev_b32 v144, 4, v0
v_add_u32 v1, s66, v144
v_add_u32 v2, 2097152, v1
v_lshlrev_b32 v3, 3, v0
v_xor_b32 v4, 128, v3
v_and_b32 v140, 0xff, v3
v_and_b32 v141, 0xff, v4
s_lshl_b32 s66, s32, 3
s_add_u32 s66, s66, s3
s_lshl_b32 s66, s66, 8
v_add_u32 v142, s66, v140
v_add_u32 v143, s66, v141
s_lshl_b32 s66, s64, 4
s_add_u32 s66, s66, s35
s_lshl_b32 s67, s65, 11
s_add_u32 s66, s66, s67
s_lshl_b32 s66, s66, 8
v_add_u32 v145, s66, v144
s_lshl_b32 s66, s65, 14
s_add_u32 s66, s66, 25600
s_add_u32 s67, s66, 32768
v_add_u32 v3, s66, v3
v_add_u32 v4, s67, v4
s_mov_b32 s6, 0x8000000
s_mov_b32 s7, 0x20000
s_mov_b32 s22, 0x8000000
s_mov_b32 s23, 0x20000
s_mov_b32 s14, 0x100000
s_mov_b32 s15, 0x20000
s_mov_b32 s18, 0x100000
s_mov_b32 s19, 0x20000
s_mov_b32 s10, 0x8000000
s_mov_b32 s11, 0x20000
s_lshl_b32 s68, s3, 12
s_add_u32 s68, s68, 25600
s_add_u32 s69, s68, 32768
s_waitcnt lgkmcnt(0)
s_mov_b32 s20, s38
s_mov_b32 s21, s39
s_mov_b32 s12, s54
s_mov_b32 s13, s55
s_mov_b32 s16, s56
s_mov_b32 s17, s57
s_mov_b32 s67, s24
global_load_dwordx2 v[152:153], v142, s[36:37]
global_load_dwordx2 v[154:155], v143, s[36:37]
global_load_dwordx2 v[156:157], v140, s[50:51]
global_load_dwordx2 v[158:159], v141, s[50:51]
global_load_dwordx2 v[160:161], v140, s[52:53]
global_load_dwordx2 v[162:163], v141, s[52:53]
s_mov_b32 m0, s68
s_nop 0
buffer_load_dwordx4 v145, s[12:15], 0 offen offset:0 nt lds
buffer_load_dwordx4 v145, s[12:15], 0 offen offset:1024 nt lds
buffer_load_dwordx4 v145, s[12:15], 0 offen offset:2048 nt lds
buffer_load_dwordx4 v145, s[12:15], 0 offen offset:3072 nt lds
s_mov_b32 m0, s69
s_nop 0
buffer_load_dwordx4 v145, s[16:19], 0 offen offset:0 nt lds
buffer_load_dwordx4 v145, s[16:19], 0 offen offset:1024 nt lds
buffer_load_dwordx4 v145, s[16:19], 0 offen offset:2048 nt lds
buffer_load_dwordx4 v145, s[16:19], 0 offen offset:3072 nt lds
buffer_load_dwordx4 v[104:107], v1, s[20:23], s24 offen nt
buffer_load_dwordx4 v[108:111], v2, s[20:23], s24 offen nt
s_add_u32 s24, s24, 1024
s_and_b32 s24, s24, 0x7fff
buffer_load_dwordx4 v[112:115], v1, s[20:23], s24 offen nt
buffer_load_dwordx4 v[116:119], v2, s[20:23], s24 offen nt
s_add_u32 s24, s24, 1024
s_and_b32 s24, s24, 0x7fff
s_mov_b32 s4, s38
s_mov_b32 s5, s39
s_mov_b32 s8, s44
s_mov_b32 s9, s45
s_mov_b32 s27, 0xffff0000
s_mov_b32 s28, 0xcccccccc
s_mov_b32 s29, 0xcccccccc
s_mov_b32 s30, 0xaaaaaaaa
s_mov_b32 s31, 0xaaaaaaaa
v_bfrev_b32 v146, v0
v_lshrrev_b32 v146, 28, v146
s_lshr_b32 s66, s67, 10
v_add_u32 v146, s66, v146
v_bfe_u32 v147, v0, 4, 1
v_lshlrev_b32 v147, 8, v147
v_lshrrev_b32 v148, 5, v0
v_lshl_add_u32 v147, v148, 1, v147
s_lshl_b32 s66, s64, 9
s_lshl_b32 s70, s65, 7
s_add_u32 s66, s66, s70
v_add_u32 v147, s66, v147
v_add_u32 v148, 0, v146
v_and_b32 v148, 31, v148
v_lshl_add_u32 v164, v148, 2, v147
v_add_u32 v148, 16, v146
v_and_b32 v148, 31, v148
v_lshl_add_u32 v165, v148, 2, v147
s_lshl_b32 s66, s32, 3
s_add_u32 s66, s66, s3
s_lshl_b32 s66, s66, 12
s_add_u32 s66, s66, s35
s_lshl_b32 s66, s66, 1
v_lshlrev_b32 v167, 2, v0
v_and_b32 v166, 0x7c, v167
v_lshrrev_b32 v148, 5, v0
v_lshl_add_u32 v166, v148, 12, v166
v_add_u32 v166, s66, v166
s_lshl_b32 s66, s3, 8
v_add_u32 v167, s66, v167
v_mov_b32 v32, 0
v_mov_b32 v33, 0
v_mov_b32 v34, 0
v_mov_b32 v35, 0
v_mov_b32 v36, 0
v_mov_b32 v37, 0
v_mov_b32 v38, 0
v_mov_b32 v39, 0
v_and_b32 v5, 32, v0
v_lshlrev_b32 v5, 2, v5
s_waitcnt vmcnt(12)
v_lshlrev_b32 v40, 16, v156
v_and_b32 v41, s27, v156
v_lshlrev_b32 v42, 16, v157
v_and_b32 v43, s27, v157
v_lshlrev_b32 v48, 16, v158
v_and_b32 v49, s27, v158
v_lshlrev_b32 v50, 16, v159
v_and_b32 v51, s27, v159
v_lshlrev_b32 v44, 16, v160
v_and_b32 v45, s27, v160
v_lshlrev_b32 v46, 16, v161
v_and_b32 v47, s27, v161
v_lshlrev_b32 v52, 16, v162
v_and_b32 v53, s27, v162
v_lshlrev_b32 v54, 16, v163
v_and_b32 v55, s27, v163
v_lshlrev_b32 v56, 16, v152
v_and_b32 v57, s27, v152
v_lshlrev_b32 v58, 16, v153
v_and_b32 v59, s27, v153
v_lshlrev_b32 v60, 16, v154
v_and_b32 v61, s27, v154
v_lshlrev_b32 v62, 16, v155
v_and_b32 v63, s27, v155
v_and_b32 v80, 16, v0
v_lshlrev_b32 v80, 27, v80
v_xor_b32 v48, v80, v48
v_xor_b32 v49, v80, v49
v_xor_b32 v50, v80, v50
v_xor_b32 v51, v80, v51
v_xor_b32 v80, 0x80000000, v80
v_xor_b32 v44, v80, v44
v_xor_b32 v45, v80, v45
v_xor_b32 v46, v80, v46
v_xor_b32 v47, v80, v47
v_pk_mul_f32 v[64:65], v[56:57], v[40:41]
v_pk_mul_f32 v[66:67], v[58:59], v[42:43]
v_pk_mul_f32 v[68:69], v[60:61], v[44:45]
v_pk_mul_f32 v[70:71], v[62:63], v[46:47]
v_pk_mul_f32 v[72:73], v[60:61], v[48:49]
v_pk_mul_f32 v[74:75], v[62:63], v[50:51]
v_pk_mul_f32 v[76:77], v[56:57], v[52:53]
v_pk_mul_f32 v[78:79], v[58:59], v[54:55]
v_cvt_pk_bf16_f32 v82, v64, v65
v_cvt_pk_bf16_f32 v83, v66, v67
v_lshlrev_b32 v64, 16, v82
v_and_b32 v65, s27, v82
v_lshlrev_b32 v66, 16, v83
v_and_b32 v67, s27, v83
v_cvt_pk_bf16_f32 v82, v68, v69
v_cvt_pk_bf16_f32 v83, v70, v71
v_lshlrev_b32 v68, 16, v82
v_and_b32 v69, s27, v82
v_lshlrev_b32 v70, 16, v83
v_and_b32 v71, s27, v83
v_cvt_pk_bf16_f32 v82, v72, v73
v_cvt_pk_bf16_f32 v83, v74, v75
v_lshlrev_b32 v72, 16, v82
v_and_b32 v73, s27, v82
v_lshlrev_b32 v74, 16, v83
v_and_b32 v75, s27, v83
v_cvt_pk_bf16_f32 v82, v76, v77
v_cvt_pk_bf16_f32 v83, v78, v79
v_lshlrev_b32 v76, 16, v82
v_and_b32 v77, s27, v82
v_lshlrev_b32 v78, 16, v83
v_and_b32 v79, s27, v83
v_pk_add_f32 v[64:65], v[64:65], v[68:69]
v_pk_add_f32 v[66:67], v[66:67], v[70:71]
v_pk_add_f32 v[72:73], v[72:73], v[76:77]
v_pk_add_f32 v[74:75], v[74:75], v[78:79]
v_cvt_pk_bf16_f32 v82, v64, v65
v_cvt_pk_bf16_f32 v83, v66, v67
v_lshlrev_b32 v64, 16, v82
v_and_b32 v65, s27, v82
v_lshlrev_b32 v66, 16, v83
v_and_b32 v67, s27, v83
v_cvt_pk_bf16_f32 v82, v72, v73
v_cvt_pk_bf16_f32 v83, v74, v75
v_lshlrev_b32 v72, 16, v82
v_and_b32 v73, s27, v82
v_lshlrev_b32 v74, 16, v83
v_and_b32 v75, s27, v83
v_and_b32 v84, 31, v0
v_lshlrev_b32 v84, 4, v84
s_lshl_b32 s66, s3, 10
s_lshl_b32 s70, s64, 11
v_add_u32 v85, s66, v84
v_add_u32 v84, s70, v84
ds_write_b128 v85, v[64:67] offset:0
ds_write_b128 v85, v[72:75] offset:512
buffer_load_dwordx4 v[120:123], v1, s[20:23], s24 offen nt
buffer_load_dwordx4 v[124:127], v2, s[20:23], s24 offen nt
s_add_u32 s24, s24, 1024
s_and_b32 s24, s24, 0x7fff
buffer_load_dwordx4 v[128:131], v1, s[20:23], s24 offen nt
buffer_load_dwordx4 v[132:135], v2, s[20:23], s24 offen nt
s_add_u32 s24, s24, 1024
s_and_b32 s24, s24, 0x7fff
s_cmp_eq_u32 s3, 0
s_cbranch_scc0 L_nocas0
s_memrealtime s[68:69]
s_waitcnt lgkmcnt(0)
s_mul_i32 s69, s69, 0x9e3779b9
s_add_u32 s68, s68, s69
s_or_b32 s68, s68, 1
s_lshl_b32 s69, s32, 5
v_mov_b32 v14, s68
v_mov_b32 v15, 0
v_mov_b32 v13, s69
s_mov_b64 exec, 1
global_atomic_cmpswap v12, v13, v[14:15], s[60:61] sc0
s_mov_b64 exec, -1
L_nocas0:
s_waitcnt vmcnt(8) lgkmcnt(0)
s_barrier
ds_read_b128 v[16:19], v84 offset:0
ds_read_b128 v[20:23], v84 offset:512
ds_read_b128 v[24:27], v84 offset:1024
ds_read_b128 v[28:31], v84 offset:1536
s_lshr_b32 s25, s67, 1
v_add_u32 v6, s25, v3
v_add_u32 v7, s25, v4
ds_read_b64 v[96:97], v6
ds_read_b64 v[98:99], v7
s_add_u32 s25, s25, 512
s_and_b32 s25, s25, 0x3fff
s_mov_b32 s26, 0
.p2align 6
L_k:
s_cmp_eq_u32 s26, 1
s_cbranch_scc0 L_nolate
global_load_dword v152, v166, s[40:41] nt
global_load_dword v153, v166, s[42:43] nt
global_load_dword v154, v166, s[46:47] nt
global_load_dword v155, v166, s[48:49] nt
L_nolate:
s_cmp_eq_u32 s26, 2
s_cbranch_scc0 L_nosw
ds_write_b32 v167, v152 offset:8192
ds_write_b32 v167, v153 offset:10240
ds_write_b32 v167, v154 offset:12288
ds_write_b32 v167, v155 offset:14336
L_nosw:
s_waitcnt lgkmcnt(0)
v_lshlrev_b32 v40, 16, v96
v_and_b32 v41, s27, v96
v_lshlrev_b32 v42, 16, v97
v_and_b32 v43, s27, v97
v_lshlrev_b32 v44, 16, v98
v_and_b32 v45, s27, v98
v_lshlrev_b32 v46, 16, v99
v_and_b32 v47, s27, v99
v_add_u32 v6, s25, v3
v_add_u32 v7, s25, v4
ds_read_b64 v[100:101], v6
ds_read_b64 v[102:103], v7
s_add_u32 s25, s25, 512
s_and_b32 s25, s25, 0x3fff
v_pk_mul_f32 v[48:49], v[16:17], v[40:41]
v_pk_mul_f32 v[50:51], v[18:19], v[42:43]
v_pk_mul_f32 v[56:57], v[24:25], v[40:41]
v_pk_mul_f32 v[58:59], v[26:27], v[42:43]
v_pk_fma_f32 v[48:49], v[20:21], v[44:45], v[48:49]
v_pk_fma_f32 v[50:51], v[22:23], v[46:47], v[50:51]
v_pk_fma_f32 v[56:57], v[28:29], v[44:45], v[56:57]
v_pk_fma_f32 v[58:59], v[30:31], v[46:47], v[58:59]
v_pk_add_f32 v[54:55], v[48:49], v[50:51]
v_pk_add_f32 v[62:63], v[56:57], v[58:59]
v_add_f32 v66, v54, v55
v_add_f32 v67, v62, v63
s_waitcnt vmcnt(7)
v_cvt_f32_i32 v104, v104
v_cvt_f32_i32 v105, v105
v_cvt_f32_i32 v106, v106
v_cvt_f32_i32 v107, v107
v_pk_mul_f32 v[52:53], v[104:105], v[48:49]
v_pk_fma_f32 v[52:53], v[106:107], v[50:51], v[52:53]
buffer_load_dwordx4 v[104:107], v1, s[20:23], s24 offen nt
v_permlane16_swap_b32 v66, v67
v_add_f32 v64, v52, v53
s_waitcnt vmcnt(7)
v_cvt_f32_i32 v108, v108
v_cvt_f32_i32 v109, v109
v_cvt_f32_i32 v110, v110
v_cvt_f32_i32 v111, v111
v_pk_mul_f32 v[60:61], v[108:109], v[56:57]
v_pk_fma_f32 v[60:61], v[110:111], v[58:59], v[60:61]
buffer_load_dwordx4 v[108:111], v2, s[20:23], s24 offen nt
v_add_f32 v65, v60, v61
s_add_u32 s24, s24, 1024
s_and_b32 s24, s24, 0x7fff
v_add_f32 v76, v66, v67
v_permlane16_swap_b32 v64, v65
v_add_f32 v68, v64, v65
s_waitcnt lgkmcnt(0)
v_lshlrev_b32 v40, 16, v100
v_and_b32 v41, s27, v100
v_lshlrev_b32 v42, 16, v101
v_and_b32 v43, s27, v101
v_lshlrev_b32 v44, 16, v102
v_and_b32 v45, s27, v102
v_lshlrev_b32 v46, 16, v103
v_and_b32 v47, s27, v103
v_add_u32 v6, s25, v3
v_add_u32 v7, s25, v4
ds_read_b64 v[96:97], v6
ds_read_b64 v[98:99], v7
s_add_u32 s25, s25, 512
s_and_b32 s25, s25, 0x3fff
v_pk_mul_f32 v[48:49], v[16:17], v[40:41]
v_pk_mul_f32 v[50:51], v[18:19], v[42:43]
v_pk_mul_f32 v[56:57], v[24:25], v[40:41]
v_pk_mul_f32 v[58:59], v[26:27], v[42:43]
v_pk_fma_f32 v[48:49], v[20:21], v[44:45], v[48:49]
v_pk_fma_f32 v[50:51], v[22:23], v[46:47], v[50:51]
v_pk_fma_f32 v[56:57], v[28:29], v[44:45], v[56:57]
v_pk_fma_f32 v[58:59], v[30:31], v[46:47], v[58:59]
v_pk_add_f32 v[54:55], v[48:49], v[50:51]
v_pk_add_f32 v[62:63], v[56:57], v[58:59]
v_add_f32 v66, v54, v55
v_add_f32 v67, v62, v63
s_waitcnt vmcnt(7)
v_cvt_f32_i32 v112, v112
v_cvt_f32_i32 v113, v113
v_cvt_f32_i32 v114, v114
v_cvt_f32_i32 v115, v115
v_pk_mul_f32 v[52:53], v[112:113], v[48:49]
v_pk_fma_f32 v[52:53], v[114:115], v[50:51], v[52:53]
buffer_load_dwordx4 v[112:115], v1, s[20:23], s24 offen nt
v_permlane16_swap_b32 v66, v67
v_add_f32 v64, v52, v53
s_waitcnt vmcnt(7)
v_cvt_f32_i32 v116, v116
v_cvt_f32_i32 v117, v117
v_cvt_f32_i32 v118, v118
v_cvt_f32_i32 v119, v119
v_pk_mul_f32 v[60:61], v[116:117], v[56:57]
v_pk_fma_f32 v[60:61], v[118:119], v[58:59], v[60:61]
buffer_load_dwordx4 v[116:119], v2, s[20:23], s24 offen nt
v_add_f32 v65, v60, v61
s_add_u32 s24, s24, 1024
s_and_b32 s24, s24, 0x7fff
s_barrier
v_add_f32 v77, v66, v67
v_permlane16_swap_b32 v64, v65
v_add_f32 v69, v64, v65
v_add_f32_dpp v76, v76, v76 row_ror:8 row_mask:0xf bank_mask:0x3
v_add_f32_dpp v68, v68, v68 row_ror:8 row_mask:0xf bank_mask:0x3
v_add_f32_dpp v76, v77, v77 row_ror:8 row_mask:0xf bank_mask:0xc
v_add_f32_dpp v68, v69, v69 row_ror:8 row_mask:0xf bank_mask:0xc
s_waitcnt lgkmcnt(0)
v_lshlrev_b32 v40, 16, v96
v_and_b32 v41, s27, v96
v_lshlrev_b32 v42, 16, v97
v_and_b32 v43, s27, v97
v_lshlrev_b32 v44, 16, v98
v_and_b32 v45, s27, v98
v_lshlrev_b32 v46, 16, v99
v_and_b32 v47, s27, v99
v_add_u32 v6, s25, v3
v_add_u32 v7, s25, v4
ds_read_b64 v[100:101], v6
ds_read_b64 v[102:103], v7
s_add_u32 s25, s25, 512
s_and_b32 s25, s25, 0x3fff
v_pk_mul_f32 v[48:49], v[16:17], v[40:41]
v_pk_mul_f32 v[50:51], v[18:19], v[42:43]
v_pk_mul_f32 v[56:57], v[24:25], v[40:41]
v_pk_mul_f32 v[58:59], v[26:27], v[42:43]
v_pk_fma_f32 v[48:49], v[20:21], v[44:45], v[48:49]
v_pk_fma_f32 v[50:51], v[22:23], v[46:47], v[50:51]
v_pk_fma_f32 v[56:57], v[28:29], v[44:45], v[56:57]
v_pk_fma_f32 v[58:59], v[30:31], v[46:47], v[58:59]
v_pk_add_f32 v[54:55], v[48:49], v[50:51]
v_pk_add_f32 v[62:63], v[56:57], v[58:59]
v_add_f32 v66, v54, v55
v_add_f32 v67, v62, v63
s_waitcnt vmcnt(7)
v_cvt_f32_i32 v120, v120
v_cvt_f32_i32 v121, v121
v_cvt_f32_i32 v122, v122
v_cvt_f32_i32 v123, v123
v_pk_mul_f32 v[52:53], v[120:121], v[48:49]
v_pk_fma_f32 v[52:53], v[122:123], v[50:51], v[52:53]
buffer_load_dwordx4 v[120:123], v1, s[20:23], s24 offen nt
v_permlane16_swap_b32 v66, v67
v_add_f32 v64, v52, v53
s_waitcnt vmcnt(7)
v_cvt_f32_i32 v124, v124
v_cvt_f32_i32 v125, v125
v_cvt_f32_i32 v126, v126
v_cvt_f32_i32 v127, v127
v_pk_mul_f32 v[60:61], v[124:125], v[56:57]
v_pk_fma_f32 v[60:61], v[126:127], v[58:59], v[60:61]
buffer_load_dwordx4 v[124:127], v2, s[20:23], s24 offen nt
v_add_f32 v65, v60, v61
s_add_u32 s24, s24, 1024
s_and_b32 s24, s24, 0x7fff
v_add_f32 v78, v66, v67
v_permlane16_swap_b32 v64, v65
v_add_f32 v70, v64, v65
s_waitcnt lgkmcnt(0)
v_lshlrev_b32 v40, 16, v100
v_and_b32 v41, s27, v100
v_lshlrev_b32 v42, 16, v101
v_and_b32 v43, s27, v101
v_lshlrev_b32 v44, 16, v102
v_and_b32 v45, s27, v102
v_lshlrev_b32 v46, 16, v103
v_and_b32 v47, s27, v103
v_add_u32 v6, s25, v3
v_add_u32 v7, s25, v4
ds_read_b64 v[96:97], v6
ds_read_b64 v[98:99], v7
s_add_u32 s25, s25, 512
s_and_b32 s25, s25, 0x3fff
v_pk_mul_f32 v[48:49], v[16:17], v[40:41]
v_pk_mul_f32 v[50:51], v[18:19], v[42:43]
v_pk_mul_f32 v[56:57], v[24:25], v[40:41]
v_pk_mul_f32 v[58:59], v[26:27], v[42:43]
v_pk_fma_f32 v[48:49], v[20:21], v[44:45], v[48:49]
v_pk_fma_f32 v[50:51], v[22:23], v[46:47], v[50:51]
v_pk_fma_f32 v[56:57], v[28:29], v[44:45], v[56:57]
v_pk_fma_f32 v[58:59], v[30:31], v[46:47], v[58:59]
v_pk_add_f32 v[54:55], v[48:49], v[50:51]
v_pk_add_f32 v[62:63], v[56:57], v[58:59]
v_add_f32 v66, v54, v55
v_add_f32 v67, v62, v63
s_waitcnt vmcnt(7)
v_cvt_f32_i32 v128, v128
v_cvt_f32_i32 v129, v129
v_cvt_f32_i32 v130, v130
v_cvt_f32_i32 v131, v131
v_pk_mul_f32 v[52:53], v[128:129], v[48:49]
v_pk_fma_f32 v[52:53], v[130:131], v[50:51], v[52:53]
buffer_load_dwordx4 v[128:131], v1, s[20:23], s24 offen nt
v_permlane16_swap_b32 v66, v67
v_add_f32 v64, v52, v53
s_waitcnt vmcnt(7)
v_cvt_f32_i32 v132, v132
v_cvt_f32_i32 v133, v133
v_cvt_f32_i32 v134, v134
v_cvt_f32_i32 v135, v135
v_pk_mul_f32 v[60:61], v[132:133], v[56:57]
v_pk_fma_f32 v[60:61], v[134:135], v[58:59], v[60:61]
buffer_load_dwordx4 v[132:135], v2, s[20:23], s24 offen nt
v_add_f32 v65, v60, v61
s_add_u32 s24, s24, 1024
s_and_b32 s24, s24, 0x7fff
s_barrier
v_add_f32 v79, v66, v67
v_permlane16_swap_b32 v64, v65
v_add_f32 v71, v64, v65
v_add_f32_dpp v78, v78, v78 row_ror:8 row_mask:0xf bank_mask:0x3
v_add_f32_dpp v70, v70, v70 row_ror:8 row_mask:0xf bank_mask:0x3
v_add_f32_dpp v78, v79, v79 row_ror:8 row_mask:0xf bank_mask:0xc
v_add_f32_dpp v70, v71, v71 row_ror:8 row_mask:0xf bank_mask:0xc
v_add_f32_dpp v76, v76, v76 row_half_mirror row_mask:0xf bank_mask:0x5
v_add_f32_dpp v68, v68, v68 row_half_mirror row_mask:0xf bank_mask:0x5
v_add_f32_dpp v76, v78, v78 row_half_mirror row_mask:0xf bank_mask:0xa
v_add_f32_dpp v68, v70, v70 row_half_mirror row_mask:0xf bank_mask:0xa
s_cmp_eq_u32 s26, 3
s_cselect_b32 s20, s8, s4
s_cselect_b32 s21, s9, s5
s_waitcnt lgkmcnt(0)
v_lshlrev_b32 v40, 16, v96
v_and_b32 v41, s27, v96
v_lshlrev_b32 v42, 16, v97
v_and_b32 v43, s27, v97
v_lshlrev_b32 v44, 16, v98
v_and_b32 v45, s27, v98
v_lshlrev_b32 v46, 16, v99
v_and_b32 v47, s27, v99
v_add_u32 v6, s25, v3
v_add_u32 v7, s25, v4
ds_read_b64 v[100:101], v6
ds_read_b64 v[102:103], v7
s_add_u32 s25, s25, 512
s_and_b32 s25, s25, 0x3fff
v_pk_mul_f32 v[48:49], v[16:17], v[40:41]
v_pk_mul_f32 v[50:51], v[18:19], v[42:43]
v_pk_mul_f32 v[56:57], v[24:25], v[40:41]
v_pk_mul_f32 v[58:59], v[26:27], v[42:43]
v_pk_fma_f32 v[48:49], v[20:21], v[44:45], v[48:49]
v_pk_fma_f32 v[50:51], v[22:23], v[46:47], v[50:51]
v_pk_fma_f32 v[56:57], v[28:29], v[44:45], v[56:57]
v_pk_fma_f32 v[58:59], v[30:31], v[46:47], v[58:59]
v_pk_add_f32 v[54:55], v[48:49], v[50:51]
v_pk_add_f32 v[62:63], v[56:57], v[58:59]
v_add_f32 v66, v54, v55
v_add_f32 v67, v62, v63
s_waitcnt vmcnt(7)
v_cvt_f32_i32 v104, v104
v_cvt_f32_i32 v105, v105
v_cvt_f32_i32 v106, v106
v_cvt_f32_i32 v107, v107
v_pk_mul_f32 v[52:53], v[104:105], v[48:49]
v_pk_fma_f32 v[52:53], v[106:107], v[50:51], v[52:53]
buffer_load_dwordx4 v[104:107], v1, s[20:23], s24 offen nt
v_permlane16_swap_b32 v66, v67
v_add_f32 v64, v52, v53
s_waitcnt vmcnt(7)
v_cvt_f32_i32 v108, v108
v_cvt_f32_i32 v109, v109
v_cvt_f32_i32 v110, v110
v_cvt_f32_i32 v111, v111
v_pk_mul_f32 v[60:61], v[108:109], v[56:57]
v_pk_fma_f32 v[60:61], v[110:111], v[58:59], v[60:61]
buffer_load_dwordx4 v[108:111], v2, s[20:23], s24 offen nt
v_add_f32 v65, v60, v61
s_add_u32 s24, s24, 1024
s_and_b32 s24, s24, 0x7fff
v_add_f32 v80, v66, v67
v_permlane16_swap_b32 v64, v65
v_add_f32 v72, v64, v65
s_waitcnt lgkmcnt(0)
v_lshlrev_b32 v40, 16, v100
v_and_b32 v41, s27, v100
v_lshlrev_b32 v42, 16, v101
v_and_b32 v43, s27, v101
v_lshlrev_b32 v44, 16, v102
v_and_b32 v45, s27, v102
v_lshlrev_b32 v46, 16, v103
v_and_b32 v47, s27, v103
v_add_u32 v6, s25, v3
v_add_u32 v7, s25, v4
ds_read_b64 v[96:97], v6
ds_read_b64 v[98:99], v7
s_add_u32 s25, s25, 512
s_and_b32 s25, s25, 0x3fff
v_pk_mul_f32 v[48:49], v[16:17], v[40:41]
v_pk_mul_f32 v[50:51], v[18:19], v[42:43]
v_pk_mul_f32 v[56:57], v[24:25], v[40:41]
v_pk_mul_f32 v[58:59], v[26:27], v[42:43]
v_pk_fma_f32 v[48:49], v[20:21], v[44:45], v[48:49]
v_pk_fma_f32 v[50:51], v[22:23], v[46:47], v[50:51]
v_pk_fma_f32 v[56:57], v[28:29], v[44:45], v[56:57]
v_pk_fma_f32 v[58:59], v[30:31], v[46:47], v[58:59]
v_pk_add_f32 v[54:55], v[48:49], v[50:51]
v_pk_add_f32 v[62:63], v[56:57], v[58:59]
v_add_f32 v66, v54, v55
v_add_f32 v67, v62, v63
s_waitcnt vmcnt(7)
v_cvt_f32_i32 v112, v112
v_cvt_f32_i32 v113, v113
v_cvt_f32_i32 v114, v114
v_cvt_f32_i32 v115, v115
v_pk_mul_f32 v[52:53], v[112:113], v[48:49]
v_pk_fma_f32 v[52:53], v[114:115], v[50:51], v[52:53]
buffer_load_dwordx4 v[112:115], v1, s[20:23], s24 offen nt
v_permlane16_swap_b32 v66, v67
v_add_f32 v64, v52, v53
s_waitcnt vmcnt(7)
v_cvt_f32_i32 v116, v116
v_cvt_f32_i32 v117, v117
v_cvt_f32_i32 v118, v118
v_cvt_f32_i32 v119, v119
v_pk_mul_f32 v[60:61], v[116:117], v[56:57]
v_pk_fma_f32 v[60:61], v[118:119], v[58:59], v[60:61]
buffer_load_dwordx4 v[116:119], v2, s[20:23], s24 offen nt
v_add_f32 v65, v60, v61
s_add_u32 s24, s24, 1024
s_and_b32 s24, s24, 0x7fff
s_barrier
v_add_f32 v81, v66, v67
v_permlane16_swap_b32 v64, v65
v_add_f32 v73, v64, v65
v_add_f32_dpp v80, v80, v80 row_ror:8 row_mask:0xf bank_mask:0x3
v_add_f32_dpp v72, v72, v72 row_ror:8 row_mask:0xf bank_mask:0x3
v_add_f32_dpp v80, v81, v81 row_ror:8 row_mask:0xf bank_mask:0xc
v_add_f32_dpp v72, v73, v73 row_ror:8 row_mask:0xf bank_mask:0xc
s_waitcnt lgkmcnt(0)
v_lshlrev_b32 v40, 16, v96
v_and_b32 v41, s27, v96
v_lshlrev_b32 v42, 16, v97
v_and_b32 v43, s27, v97
v_lshlrev_b32 v44, 16, v98
v_and_b32 v45, s27, v98
v_lshlrev_b32 v46, 16, v99
v_and_b32 v47, s27, v99
v_add_u32 v6, s25, v3
v_add_u32 v7, s25, v4
ds_read_b64 v[100:101], v6
ds_read_b64 v[102:103], v7
s_add_u32 s25, s25, 512
s_and_b32 s25, s25, 0x3fff
v_pk_mul_f32 v[48:49], v[16:17], v[40:41]
v_pk_mul_f32 v[50:51], v[18:19], v[42:43]
v_pk_mul_f32 v[56:57], v[24:25], v[40:41]
v_pk_mul_f32 v[58:59], v[26:27], v[42:43]
v_pk_fma_f32 v[48:49], v[20:21], v[44:45], v[48:49]
v_pk_fma_f32 v[50:51], v[22:23], v[46:47], v[50:51]
v_pk_fma_f32 v[56:57], v[28:29], v[44:45], v[56:57]
v_pk_fma_f32 v[58:59], v[30:31], v[46:47], v[58:59]
v_pk_add_f32 v[54:55], v[48:49], v[50:51]
v_pk_add_f32 v[62:63], v[56:57], v[58:59]
v_add_f32 v66, v54, v55
v_add_f32 v67, v62, v63
s_waitcnt vmcnt(7)
v_cvt_f32_i32 v120, v120
v_cvt_f32_i32 v121, v121
v_cvt_f32_i32 v122, v122
v_cvt_f32_i32 v123, v123
v_pk_mul_f32 v[52:53], v[120:121], v[48:49]
v_pk_fma_f32 v[52:53], v[122:123], v[50:51], v[52:53]
buffer_load_dwordx4 v[120:123], v1, s[20:23], s24 offen nt
v_permlane16_swap_b32 v66, v67
v_add_f32 v64, v52, v53
s_waitcnt vmcnt(7)
v_cvt_f32_i32 v124, v124
v_cvt_f32_i32 v125, v125
v_cvt_f32_i32 v126, v126
v_cvt_f32_i32 v127, v127
v_pk_mul_f32 v[60:61], v[124:125], v[56:57]
v_pk_fma_f32 v[60:61], v[126:127], v[58:59], v[60:61]
buffer_load_dwordx4 v[124:127], v2, s[20:23], s24 offen nt
v_add_f32 v65, v60, v61
s_add_u32 s24, s24, 1024
s_and_b32 s24, s24, 0x7fff
v_add_f32 v82, v66, v67
v_permlane16_swap_b32 v64, v65
v_add_f32 v74, v64, v65
s_waitcnt lgkmcnt(0)
v_lshlrev_b32 v40, 16, v100
v_and_b32 v41, s27, v100
v_lshlrev_b32 v42, 16, v101
v_and_b32 v43, s27, v101
v_lshlrev_b32 v44, 16, v102
v_and_b32 v45, s27, v102
v_lshlrev_b32 v46, 16, v103
v_and_b32 v47, s27, v103
v_add_u32 v6, s25, v3
v_add_u32 v7, s25, v4
ds_read_b64 v[96:97], v6
ds_read_b64 v[98:99], v7
s_add_u32 s25, s25, 512
s_and_b32 s25, s25, 0x3fff
v_pk_mul_f32 v[48:49], v[16:17], v[40:41]
v_pk_mul_f32 v[50:51], v[18:19], v[42:43]
v_pk_mul_f32 v[56:57], v[24:25], v[40:41]
v_pk_mul_f32 v[58:59], v[26:27], v[42:43]
v_pk_fma_f32 v[48:49], v[20:21], v[44:45], v[48:49]
v_pk_fma_f32 v[50:51], v[22:23], v[46:47], v[50:51]
v_pk_fma_f32 v[56:57], v[28:29], v[44:45], v[56:57]
v_pk_fma_f32 v[58:59], v[30:31], v[46:47], v[58:59]
v_pk_add_f32 v[54:55], v[48:49], v[50:51]
v_pk_add_f32 v[62:63], v[56:57], v[58:59]
v_add_f32 v66, v54, v55
v_add_f32 v67, v62, v63
s_waitcnt vmcnt(7)
v_cvt_f32_i32 v128, v128
v_cvt_f32_i32 v129, v129
v_cvt_f32_i32 v130, v130
v_cvt_f32_i32 v131, v131
v_pk_mul_f32 v[52:53], v[128:129], v[48:49]
v_pk_fma_f32 v[52:53], v[130:131], v[50:51], v[52:53]
buffer_load_dwordx4 v[128:131], v1, s[20:23], s24 offen nt
v_permlane16_swap_b32 v66, v67
v_add_f32 v64, v52, v53
s_waitcnt vmcnt(7)
v_cvt_f32_i32 v132, v132
v_cvt_f32_i32 v133, v133
v_cvt_f32_i32 v134, v134
v_cvt_f32_i32 v135, v135
v_pk_mul_f32 v[60:61], v[132:133], v[56:57]
v_pk_fma_f32 v[60:61], v[134:135], v[58:59], v[60:61]
buffer_load_dwordx4 v[132:135], v2, s[20:23], s24 offen nt
v_add_f32 v65, v60, v61
s_add_u32 s24, s24, 1024
s_and_b32 s24, s24, 0x7fff
s_barrier
v_add_f32 v83, v66, v67
v_permlane16_swap_b32 v64, v65
v_add_f32 v75, v64, v65
v_add_f32_dpp v82, v82, v82 row_ror:8 row_mask:0xf bank_mask:0x3
v_add_f32_dpp v74, v74, v74 row_ror:8 row_mask:0xf bank_mask:0x3
v_add_f32_dpp v82, v83, v83 row_ror:8 row_mask:0xf bank_mask:0xc
v_add_f32_dpp v74, v75, v75 row_ror:8 row_mask:0xf bank_mask:0xc
v_add_f32_dpp v80, v80, v80 row_half_mirror row_mask:0xf bank_mask:0x5
v_add_f32_dpp v72, v72, v72 row_half_mirror row_mask:0xf bank_mask:0x5
v_add_f32_dpp v80, v82, v82 row_half_mirror row_mask:0xf bank_mask:0xa
v_add_f32_dpp v72, v74, v74 row_half_mirror row_mask:0xf bank_mask:0xa
v_cndmask_b32 v84, v80, v76, s[28:29]
v_cndmask_b32 v85, v76, v80, s[28:29]
v_mov_b32 v95, v94
v_mov_b32 v94, v93
v_mov_b32 v93, v92
v_cndmask_b32 v86, v72, v68, s[28:29]
v_cndmask_b32 v87, v68, v72, s[28:29]
v_mov_b32 v91, v90
v_mov_b32 v90, v89
v_mov_b32 v89, v88
v_add_f32_dpp v92, v84, v85 quad_perm:[2,3,0,1] row_mask:0xf bank_mask:0xf
v_add_f32_dpp v88, v86, v87 quad_perm:[2,3,0,1] row_mask:0xf bank_mask:0xf
s_add_u32 s26, s26, 1
s_cmp_lt_u32 s26, 4
s_cbranch_scc1 L_k
s_waitcnt lgkmcnt(0)
ds_read_u16_d16_hi v32, v164 offset:8192
ds_read_u16_d16_hi v34, v164 offset:10240
ds_read_u16_d16_hi v36, v164 offset:12288
ds_read_u16_d16_hi v38, v164 offset:14336
ds_read_u16_d16_hi v33, v165 offset:8192
ds_read_u16_d16_hi v35, v165 offset:10240
ds_read_u16_d16_hi v37, v165 offset:12288
ds_read_u16_d16_hi v39, v165 offset:14336
s_cmp_eq_u32 s3, 0
s_cbranch_scc0 L_nopub
v_cmp_eq_u32 vcc, 0, v12
s_nop 1
v_cndmask_b32 v12, v12, v14, vcc
v_mov_b32 v13, 24832
s_mov_b64 exec, 1
ds_write_b32 v13, v12
s_mov_b64 exec, -1
L_nopub:
v_cndmask_b32 v68, v94, v95, s[30:31]
v_cndmask_b32 v69, v95, v94, s[30:31]
v_cndmask_b32 v70, v92, v93, s[30:31]
v_cndmask_b32 v71, v93, v92, s[30:31]
v_cndmask_b32 v72, v90, v91, s[30:31]
v_cndmask_b32 v73, v91, v90, s[30:31]
v_cndmask_b32 v74, v88, v89, s[30:31]
v_cndmask_b32 v75, v89, v88, s[30:31]
v_add_f32_dpp v66, v68, v69 quad_perm:[1,0,3,2] row_mask:0xf bank_mask:0xf
v_add_f32_dpp v67, v70, v71 quad_perm:[1,0,3,2] row_mask:0xf bank_mask:0xf
v_add_f32_dpp v64, v72, v73 quad_perm:[1,0,3,2] row_mask:0xf bank_mask:0xf
v_add_f32_dpp v65, v74, v75 quad_perm:[1,0,3,2] row_mask:0xf bank_mask:0xf
s_waitcnt lgkmcnt(0)
s_mov_b32 s66, 0x3e0293ee
v_fma_f32 v64, -v34, v66, v64
v_mul_f32 v32, s66, v32
v_fma_f32 v65, -v35, v67, v65
v_mul_f32 v33, s66, v33
v_mul_f32 v64, v64, v32
v_mul_f32 v65, v65, v33
v_max_f32 v68, v64, v65
s_nop 1
v_max_f32_dpp v68, v68, v68 quad_perm:[1,0,3,2] row_mask:0xf bank_mask:0xf
s_nop 1
v_max_f32_dpp v68, v68, v68 quad_perm:[2,3,0,1] row_mask:0xf bank_mask:0xf
s_nop 1
v_max_f32_dpp v68, v68, v68 row_half_mirror row_mask:0xf bank_mask:0xf
s_nop 1
v_max_f32_dpp v68, v68, v68 row_mirror row_mask:0xf bank_mask:0xf
v_mov_b32 v71, v68
s_nop 1
v_permlane32_swap_b32 v71, v68
v_max_f32 v68, v68, v71
v_sub_f32 v72, v64, v68
v_sub_f32 v73, v65, v68
v_exp_f32 v72, v72
v_exp_f32 v73, v73
s_nop 0
v_add_f32 v69, v72, v73
v_mul_f32 v76, v72, v36
v_mul_f32 v78, v73, v37
v_mul_f32 v70, v76, v38
v_mov_b32 v77, v76
v_fmac_f32 v70, v78, v39
v_mov_b32 v79, v78
v_add_f32_dpp v69, v69, v69 quad_perm:[1,0,3,2] row_mask:0xf bank_mask:0xf
s_nop 1
v_add_f32_dpp v69, v69, v69 quad_perm:[2,3,0,1] row_mask:0xf bank_mask:0xf
s_nop 1
v_add_f32_dpp v69, v69, v69 row_half_mirror row_mask:0xf bank_mask:0xf
s_nop 1
v_add_f32_dpp v69, v69, v69 row_mirror row_mask:0xf bank_mask:0xf
v_mov_b32 v71, v69
s_nop 1
v_permlane32_swap_b32 v71, v69
v_add_f32 v69, v69, v71
v_add_f32_dpp v70, v70, v70 quad_perm:[1,0,3,2] row_mask:0xf bank_mask:0xf
s_nop 1
v_add_f32_dpp v70, v70, v70 quad_perm:[2,3,0,1] row_mask:0xf bank_mask:0xf
s_nop 1
v_add_f32_dpp v70, v70, v70 row_half_mirror row_mask:0xf bank_mask:0xf
s_nop 1
v_add_f32_dpp v70, v70, v70 row_mirror row_mask:0xf bank_mask:0xf
v_mov_b32 v74, v70
s_nop 1
v_permlane32_swap_b32 v74, v70
v_add_f32 v70, v70, v74
v_mov_b32 v16, 0
v_mov_b32 v17, 0
v_mov_b32 v18, 0
v_mov_b32 v19, 0
v_mov_b32 v20, 0
v_mov_b32 v21, 0
v_mov_b32 v22, 0
v_mov_b32 v23, 0
s_mov_b32 s26, 0
.p2align 6
L_v:
ds_bpermute_b32 v40, v5, v76 offset:0
ds_bpermute_b32 v41, v5, v76 offset:64
ds_bpermute_b32 v42, v5, v76 offset:32
ds_bpermute_b32 v43, v5, v76 offset:96
ds_bpermute_b32 v44, v5, v76 offset:16
ds_bpermute_b32 v45, v5, v76 offset:80
ds_bpermute_b32 v46, v5, v76 offset:48
ds_bpermute_b32 v47, v5, v76 offset:112
ds_bpermute_b32 v48, v5, v76 offset:8
ds_bpermute_b32 v49, v5, v76 offset:72
ds_bpermute_b32 v50, v5, v76 offset:40
ds_bpermute_b32 v51, v5, v76 offset:104
ds_bpermute_b32 v52, v5, v76 offset:24
ds_bpermute_b32 v53, v5, v76 offset:88
ds_bpermute_b32 v54, v5, v76 offset:56
ds_bpermute_b32 v55, v5, v76 offset:120
v_xor_b32 v5, 4, v5
s_waitcnt vmcnt(7) lgkmcnt(15)
v_cvt_f32_i32 v104, v104
v_cvt_f32_i32 v105, v105
v_cvt_f32_i32 v106, v106
v_cvt_f32_i32 v107, v107
v_pk_fma_f32 v[16:17], v[104:105], v[40:41], v[16:17] op_sel_hi:[1,0,1]
v_pk_fma_f32 v[18:19], v[106:107], v[40:41], v[18:19] op_sel_hi:[1,0,1]
buffer_load_dwordx4 v[104:107], v1, s[8:11], s24 offen nt
s_waitcnt vmcnt(7) lgkmcnt(14)
v_cvt_f32_i32 v108, v108
v_cvt_f32_i32 v109, v109
v_cvt_f32_i32 v110, v110
v_cvt_f32_i32 v111, v111
v_pk_fma_f32 v[20:21], v[108:109], v[40:41], v[20:21] op_sel:[0,1,0] op_sel_hi:[1,1,1]
v_pk_fma_f32 v[22:23], v[110:111], v[40:41], v[22:23] op_sel:[0,1,0] op_sel_hi:[1,1,1]
buffer_load_dwordx4 v[108:111], v2, s[8:11], s24 offen nt
s_add_u32 s24, s24, 1024
s_and_b32 s24, s24, 0x7fff
s_waitcnt vmcnt(7) lgkmcnt(13)
v_cvt_f32_i32 v112, v112
v_cvt_f32_i32 v113, v113
v_cvt_f32_i32 v114, v114
v_cvt_f32_i32 v115, v115
v_pk_fma_f32 v[16:17], v[112:113], v[42:43], v[16:17] op_sel_hi:[1,0,1]
v_pk_fma_f32 v[18:19], v[114:115], v[42:43], v[18:19] op_sel_hi:[1,0,1]
buffer_load_dwordx4 v[112:115], v1, s[8:11], s24 offen nt
s_waitcnt vmcnt(7) lgkmcnt(12)
v_cvt_f32_i32 v116, v116
v_cvt_f32_i32 v117, v117
v_cvt_f32_i32 v118, v118
v_cvt_f32_i32 v119, v119
v_pk_fma_f32 v[20:21], v[116:117], v[42:43], v[20:21] op_sel:[0,1,0] op_sel_hi:[1,1,1]
v_pk_fma_f32 v[22:23], v[118:119], v[42:43], v[22:23] op_sel:[0,1,0] op_sel_hi:[1,1,1]
buffer_load_dwordx4 v[116:119], v2, s[8:11], s24 offen nt
s_add_u32 s24, s24, 1024
s_and_b32 s24, s24, 0x7fff
s_barrier
s_waitcnt vmcnt(7) lgkmcnt(11)
v_cvt_f32_i32 v120, v120
v_cvt_f32_i32 v121, v121
v_cvt_f32_i32 v122, v122
v_cvt_f32_i32 v123, v123
v_pk_fma_f32 v[16:17], v[120:121], v[44:45], v[16:17] op_sel_hi:[1,0,1]
v_pk_fma_f32 v[18:19], v[122:123], v[44:45], v[18:19] op_sel_hi:[1,0,1]
buffer_load_dwordx4 v[120:123], v1, s[8:11], s24 offen nt
s_waitcnt vmcnt(7) lgkmcnt(10)
v_cvt_f32_i32 v124, v124
v_cvt_f32_i32 v125, v125
v_cvt_f32_i32 v126, v126
v_cvt_f32_i32 v127, v127
v_pk_fma_f32 v[20:21], v[124:125], v[44:45], v[20:21] op_sel:[0,1,0] op_sel_hi:[1,1,1]
v_pk_fma_f32 v[22:23], v[126:127], v[44:45], v[22:23] op_sel:[0,1,0] op_sel_hi:[1,1,1]
buffer_load_dwordx4 v[124:127], v2, s[8:11], s24 offen nt
s_add_u32 s24, s24, 1024
s_and_b32 s24, s24, 0x7fff
s_waitcnt vmcnt(7) lgkmcnt(9)
v_cvt_f32_i32 v128, v128
v_cvt_f32_i32 v129, v129
v_cvt_f32_i32 v130, v130
v_cvt_f32_i32 v131, v131
v_pk_fma_f32 v[16:17], v[128:129], v[46:47], v[16:17] op_sel_hi:[1,0,1]
v_pk_fma_f32 v[18:19], v[130:131], v[46:47], v[18:19] op_sel_hi:[1,0,1]
buffer_load_dwordx4 v[128:131], v1, s[8:11], s24 offen nt
s_waitcnt vmcnt(7) lgkmcnt(8)
v_cvt_f32_i32 v132, v132
v_cvt_f32_i32 v133, v133
v_cvt_f32_i32 v134, v134
v_cvt_f32_i32 v135, v135
v_pk_fma_f32 v[20:21], v[132:133], v[46:47], v[20:21] op_sel:[0,1,0] op_sel_hi:[1,1,1]
v_pk_fma_f32 v[22:23], v[134:135], v[46:47], v[22:23] op_sel:[0,1,0] op_sel_hi:[1,1,1]
buffer_load_dwordx4 v[132:135], v2, s[8:11], s24 offen nt
s_add_u32 s24, s24, 1024
s_and_b32 s24, s24, 0x7fff
s_barrier
s_cmp_eq_u32 s26, 3
s_cselect_b32 s10, 0, s10
s_waitcnt vmcnt(7) lgkmcnt(7)
v_cvt_f32_i32 v104, v104
v_cvt_f32_i32 v105, v105
v_cvt_f32_i32 v106, v106
v_cvt_f32_i32 v107, v107
v_pk_fma_f32 v[16:17], v[104:105], v[48:49], v[16:17] op_sel_hi:[1,0,1]
v_pk_fma_f32 v[18:19], v[106:107], v[48:49], v[18:19] op_sel_hi:[1,0,1]
buffer_load_dwordx4 v[104:107], v1, s[8:11], s24 offen nt
s_waitcnt vmcnt(7) lgkmcnt(6)
v_cvt_f32_i32 v108, v108
v_cvt_f32_i32 v109, v109
v_cvt_f32_i32 v110, v110
v_cvt_f32_i32 v111, v111
v_pk_fma_f32 v[20:21], v[108:109], v[48:49], v[20:21] op_sel:[0,1,0] op_sel_hi:[1,1,1]
v_pk_fma_f32 v[22:23], v[110:111], v[48:49], v[22:23] op_sel:[0,1,0] op_sel_hi:[1,1,1]
buffer_load_dwordx4 v[108:111], v2, s[8:11], s24 offen nt
s_add_u32 s24, s24, 1024
s_and_b32 s24, s24, 0x7fff
s_waitcnt vmcnt(7) lgkmcnt(5)
v_cvt_f32_i32 v112, v112
v_cvt_f32_i32 v113, v113
v_cvt_f32_i32 v114, v114
v_cvt_f32_i32 v115, v115
v_pk_fma_f32 v[16:17], v[112:113], v[50:51], v[16:17] op_sel_hi:[1,0,1]
v_pk_fma_f32 v[18:19], v[114:115], v[50:51], v[18:19] op_sel_hi:[1,0,1]
buffer_load_dwordx4 v[112:115], v1, s[8:11], s24 offen nt
s_waitcnt vmcnt(7) lgkmcnt(4)
v_cvt_f32_i32 v116, v116
v_cvt_f32_i32 v117, v117
v_cvt_f32_i32 v118, v118
v_cvt_f32_i32 v119, v119
v_pk_fma_f32 v[20:21], v[116:117], v[50:51], v[20:21] op_sel:[0,1,0] op_sel_hi:[1,1,1]
v_pk_fma_f32 v[22:23], v[118:119], v[50:51], v[22:23] op_sel:[0,1,0] op_sel_hi:[1,1,1]
buffer_load_dwordx4 v[116:119], v2, s[8:11], s24 offen nt
s_add_u32 s24, s24, 1024
s_and_b32 s24, s24, 0x7fff
s_barrier
s_waitcnt vmcnt(7) lgkmcnt(3)
v_cvt_f32_i32 v120, v120
v_cvt_f32_i32 v121, v121
v_cvt_f32_i32 v122, v122
v_cvt_f32_i32 v123, v123
v_pk_fma_f32 v[16:17], v[120:121], v[52:53], v[16:17] op_sel_hi:[1,0,1]
v_pk_fma_f32 v[18:19], v[122:123], v[52:53], v[18:19] op_sel_hi:[1,0,1]
buffer_load_dwordx4 v[120:123], v1, s[8:11], s24 offen nt
s_waitcnt vmcnt(7) lgkmcnt(2)
v_cvt_f32_i32 v124, v124
v_cvt_f32_i32 v125, v125
v_cvt_f32_i32 v126, v126
v_cvt_f32_i32 v127, v127
v_pk_fma_f32 v[20:21], v[124:125], v[52:53], v[20:21] op_sel:[0,1,0] op_sel_hi:[1,1,1]
v_pk_fma_f32 v[22:23], v[126:127], v[52:53], v[22:23] op_sel:[0,1,0] op_sel_hi:[1,1,1]
buffer_load_dwordx4 v[124:127], v2, s[8:11], s24 offen nt
s_add_u32 s24, s24, 1024
s_and_b32 s24, s24, 0x7fff
s_waitcnt vmcnt(7) lgkmcnt(1)
v_cvt_f32_i32 v128, v128
v_cvt_f32_i32 v129, v129
v_cvt_f32_i32 v130, v130
v_cvt_f32_i32 v131, v131
v_pk_fma_f32 v[16:17], v[128:129], v[54:55], v[16:17] op_sel_hi:[1,0,1]
v_pk_fma_f32 v[18:19], v[130:131], v[54:55], v[18:19] op_sel_hi:[1,0,1]
buffer_load_dwordx4 v[128:131], v1, s[8:11], s24 offen nt
s_waitcnt vmcnt(7) lgkmcnt(0)
v_cvt_f32_i32 v132, v132
v_cvt_f32_i32 v133, v133
v_cvt_f32_i32 v134, v134
v_cvt_f32_i32 v135, v135
v_pk_fma_f32 v[20:21], v[132:133], v[54:55], v[20:21] op_sel:[0,1,0] op_sel_hi:[1,1,1]
v_pk_fma_f32 v[22:23], v[134:135], v[54:55], v[22:23] op_sel:[0,1,0] op_sel_hi:[1,1,1]
buffer_load_dwordx4 v[132:135], v2, s[8:11], s24 offen nt
s_add_u32 s24, s24, 1024
s_and_b32 s24, s24, 0x7fff
s_barrier
v_mov_b32 v76, v77
v_mov_b32 v77, v78
v_mov_b32 v78, v79
s_add_u32 s26, s26, 1
s_cmp_lt_u32 s26, 4
s_cbranch_scc1 L_v
v_lshrrev_b32 v24, 5, v0
v_lshlrev_b32 v24, 6, v24
ds_bpermute_b32 v25, v24, v70
v_permlane32_swap_b32 v16, v20
v_permlane32_swap_b32 v17, v21
v_permlane32_swap_b32 v18, v22
v_permlane32_swap_b32 v19, v23
v_add_f32 v16, v16, v20
v_add_f32 v17, v17, v21
v_add_f32 v18, v18, v22
v_add_f32 v19, v19, v23
s_lshl_b32 s66, s3, 10
v_lshlrev_b32 v26, 4, v0
v_add_u32 v26, s66, v26
v_and_b32 v27, 16, v0
s_lshl_b32 s66, s64, 5
s_lshl_b32 s70, s65, 3
s_add_u32 s66, s66, s70
v_add_u32 v27, s66, v27
ds_write_b64 v27, v[68:69] offset:24576
s_waitcnt lgkmcnt(1)
v_sub_f32 v16, v16, v25
v_sub_f32 v17, v17, v25
v_sub_f32 v18, v18, v25
v_sub_f32 v19, v19, v25
ds_write_b128 v26, v[16:19] offset:16384
s_waitcnt lgkmcnt(0)
s_barrier
v_lshrrev_b32 v24, 5, v0
v_and_b32 v25, 31, v0
v_lshlrev_b32 v26, 4, v25
s_lshr_b32 s66, s3, 1
s_lshl_b32 s66, s66, 10
s_and_b32 s70, s3, 1
s_lshl_b32 s70, s70, 9
s_add_u32 s66, s66, s70
v_lshl_add_u32 v26, v24, 12, v26
v_add_u32 v26, s66, v26
s_lshl_b32 s66, s3, 4
v_lshlrev_b32 v27, 3, v24
v_add_u32 v27, s66, v27
v_mov_b32 v28, 24832
ds_read_b32 v28, v28
ds_read_b64 v[32:33], v27 offset:24576
ds_read_b128 v[8:11], v26 offset:16384
s_waitcnt lgkmcnt(1)
v_not_b32 v29, v28
v_mov_b32 v14, v32
v_mov_b32 v12, v32
s_nop 1
v_permlane32_swap_b32 v14, v12
v_max_f32 v12, v12, v14
v_sub_f32 v32, v32, v12
v_exp_f32 v32, v32
s_nop 0
v_mul_f32 v13, v32, v33
s_waitcnt lgkmcnt(0)
v_mul_f32 v8, v32, v8
v_mul_f32 v9, v32, v9
v_mul_f32 v10, v32, v10
v_mul_f32 v11, v32, v11
v_mov_b32 v16, v8
v_mov_b32 v17, v9
v_mov_b32 v18, v10
v_mov_b32 v19, v11
v_mov_b32 v20, v13
v_permlane32_swap_b32 v16, v8
v_permlane32_swap_b32 v17, v9
v_permlane32_swap_b32 v18, v10
v_permlane32_swap_b32 v19, v11
v_permlane32_swap_b32 v20, v13
v_add_f32 v8, v8, v16
v_add_f32 v9, v9, v17
v_add_f32 v10, v10, v18
v_add_f32 v11, v11, v19
v_add_f32 v13, v13, v20
s_lshl_b32 s66, s32, 3
s_add_u32 s66, s66, s3
s_lshl_b32 s67, s34, 2
s_add_u32 s67, s67, s33
s_lshl_b32 s72, s66, 5
s_add_u32 s72, s72, s67
s_mov_b32 s76, s62
s_mov_b32 s77, s63
s_mov_b32 s78, 0x300000
s_mov_b32 s79, 0x20000
s_lshl_b32 s73, s72, 10
s_lshl_b32 s74, s72, 4
s_add_u32 s74, s74, 0x200000
s_mov_b32 s70, 0
s_mov_b32 s71, -1
v_cndmask_b32 v16, v8, v10, s[70:71]
v_mov_b32 v17, v28
v_cndmask_b32 v18, v9, v11, s[70:71]
v_mov_b32 v19, v29
v_mov_b32 v20, v12
v_mov_b32 v21, v28
v_mov_b32 v22, v13
v_mov_b32 v23, v29
v_lshlrev_b32 v26, 5, v25
v_lshl_add_u32 v26, v24, 4, v26
v_mov_b32 v27, 0
buffer_store_dwordx4 v[16:19], v26, s[76:79], s73 offen sc1
s_mov_b64 exec, 1
buffer_store_dwordx4 v[20:23], v27, s[76:79], s74 offen sc1
s_mov_b64 exec, -1
s_and_b32 s67, s32, 3
s_cmp_eq_u32 s67, s33
s_cbranch_scc0 L_dump
s_lshl_b32 s66, s32, 3
s_add_u32 s66, s66, s34
s_lshl_b32 s72, s66, 5
s_lshl_b32 s67, s3, 2
s_add_u32 s72, s72, s67
s_lshl_b32 s73, s72, 10
s_lshl_b32 s74, s72, 4
s_add_u32 s74, s74, 0x200000
v_and_b32 v27, 3, v0
v_lshlrev_b32 v27, 4, v27
s_mov_b32 s75, 0
L_poll:
s_bitcmp1_b32 s75, 0
s_cbranch_scc1 L_sk0
buffer_load_dwordx4 v[32:35], v26, s[76:79], s73 offen offset:0 sc1
L_sk0:
s_bitcmp1_b32 s75, 1
s_cbranch_scc1 L_sk1
buffer_load_dwordx4 v[36:39], v26, s[76:79], s73 offen offset:1024 sc1
L_sk1:
s_bitcmp1_b32 s75, 2
s_cbranch_scc1 L_sk2
buffer_load_dwordx4 v[40:43], v26, s[76:79], s73 offen offset:2048 sc1
L_sk2:
s_bitcmp1_b32 s75, 3
s_cbranch_scc1 L_sk3
buffer_load_dwordx4 v[44:47], v26, s[76:79], s73 offen offset:3072 sc1
L_sk3:
buffer_load_dwordx4 v[48:51], v27, s[76:79], s74 offen sc1
s_waitcnt vmcnt(0)
v_cmp_ne_u32 vcc, v33, v28
v_cmp_ne_u32 s[70:71], v35, v29
s_or_b64 vcc, vcc, s[70:71]
s_cmp_eq_u64 vcc, 0
s_cselect_b32 s67, 1, 0
s_or_b32 s75, s75, s67
v_cmp_ne_u32 vcc, v37, v28
v_cmp_ne_u32 s[70:71], v39, v29
s_or_b64 vcc, vcc, s[70:71]
s_cmp_eq_u64 vcc, 0
s_cselect_b32 s67, 2, 0
s_or_b32 s75, s75, s67
v_cmp_ne_u32 vcc, v41, v28
v_cmp_ne_u32 s[70:71], v43, v29
s_or_b64 vcc, vcc, s[70:71]
s_cmp_eq_u64 vcc, 0
s_cselect_b32 s67, 4, 0
s_or_b32 s75, s75, s67
v_cmp_ne_u32 vcc, v45, v28
v_cmp_ne_u32 s[70:71], v47, v29
s_or_b64 vcc, vcc, s[70:71]
s_cmp_eq_u64 vcc, 0
s_cselect_b32 s67, 8, 0
s_or_b32 s75, s75, s67
v_cmp_ne_u32 vcc, v49, v28
v_cmp_ne_u32 s[70:71], v51, v29
s_or_b64 vcc, vcc, s[70:71]
s_cmp_eq_u64 vcc, 0
s_cselect_b32 s67, 16, 0
s_or_b32 s75, s75, s67
s_cmp_eq_u32 s75, 31
s_cbranch_scc1 L_pdone
s_and_b32 s75, s75, 15
s_branch L_poll
L_pdone:
v_max_f32_dpp v52, v48, v48 quad_perm:[1,0,3,2] row_mask:0xf bank_mask:0xf
s_nop 1
v_max_f32_dpp v52, v52, v52 quad_perm:[2,3,0,1] row_mask:0xf bank_mask:0xf
v_sub_f32 v53, v48, v52
v_exp_f32 v53, v53
s_nop 0
v_mul_f32 v54, v53, v50
v_mov_b32_dpp v56, v53 quad_perm:[0,0,0,0] row_mask:0xf bank_mask:0xf
v_mov_b32_dpp v57, v53 quad_perm:[1,1,1,1] row_mask:0xf bank_mask:0xf
v_mov_b32_dpp v58, v53 quad_perm:[2,2,2,2] row_mask:0xf bank_mask:0xf
v_mov_b32_dpp v59, v53 quad_perm:[3,3,3,3] row_mask:0xf bank_mask:0xf
v_add_f32_dpp v54, v54, v54 quad_perm:[1,0,3,2] row_mask:0xf bank_mask:0xf
v_mul_f32 v60, v56, v32
v_mul_f32 v61, v56, v34
v_add_f32_dpp v54, v54, v54 quad_perm:[2,3,0,1] row_mask:0xf bank_mask:0xf
v_fmac_f32 v60, v57, v36
v_fmac_f32 v61, v57, v38
v_fmac_f32 v60, v58, v40
v_fmac_f32 v61, v58, v42
v_fmac_f32 v60, v59, v44
v_fmac_f32 v61, v59, v46
s_lshl_b32 s67, s3, 9
v_lshlrev_b32 v62, 3, v0
v_add_u32 v63, s67, v62
s_lshl_b32 s67, s3, 2
v_mov_b32 v55, s67
ds_write_b64 v63, v[60:61] offset:0
ds_write_b32 v55, v52 offset:4096
ds_write_b32 v55, v54 offset:4128
s_waitcnt lgkmcnt(0)
s_barrier
s_cmp_eq_u32 s3, 0
s_cbranch_scc0 L_dump
v_mov_b32 v55, 4096
ds_read_b128 v[32:35], v55
ds_read_b128 v[36:39], v55 offset:16
ds_read_b128 v[40:43], v55 offset:32
ds_read_b128 v[44:47], v55 offset:48
ds_read_b64 v[64:65], v62 offset:0
ds_read_b64 v[66:67], v62 offset:512
ds_read_b64 v[68:69], v62 offset:1024
ds_read_b64 v[70:71], v62 offset:1536
ds_read_b64 v[72:73], v62 offset:2048
ds_read_b64 v[74:75], v62 offset:2560
ds_read_b64 v[76:77], v62 offset:3072
ds_read_b64 v[78:79], v62 offset:3584
s_waitcnt lgkmcnt(8)
v_max3_f32 v12, v32, v33, v34
v_max3_f32 v12, v12, v35, v36
v_max3_f32 v12, v12, v37, v38
v_max_f32 v12, v12, v39
v_sub_f32 v32, v32, v12
v_sub_f32 v33, v33, v12
v_sub_f32 v34, v34, v12
v_sub_f32 v35, v35, v12
v_sub_f32 v36, v36, v12
v_sub_f32 v37, v37, v12
v_sub_f32 v38, v38, v12
v_sub_f32 v39, v39, v12
v_exp_f32 v32, v32
v_exp_f32 v33, v33
v_exp_f32 v34, v34
v_exp_f32 v35, v35
v_exp_f32 v36, v36
v_exp_f32 v37, v37
v_exp_f32 v38, v38
v_exp_f32 v39, v39
v_mul_f32 v13, v32, v40
v_fmac_f32 v13, v33, v41
v_fmac_f32 v13, v34, v42
v_fmac_f32 v13, v35, v43
v_fmac_f32 v13, v36, v44
v_fmac_f32 v13, v37, v45
v_fmac_f32 v13, v38, v46
v_fmac_f32 v13, v39, v47
v_rcp_f32 v13, v13
s_waitcnt lgkmcnt(0)
v_mul_f32 v8, v32, v64
v_mul_f32 v9, v32, v65
v_fmac_f32 v8, v33, v66
v_fmac_f32 v9, v33, v67
v_fmac_f32 v8, v34, v68
v_fmac_f32 v9, v34, v69
v_fmac_f32 v8, v35, v70
v_fmac_f32 v9, v35, v71
v_fmac_f32 v8, v36, v72
v_fmac_f32 v9, v36, v73
v_fmac_f32 v8, v37, v74
v_fmac_f32 v9, v37, v75
v_fmac_f32 v8, v38, v76
v_fmac_f32 v9, v38, v77
v_fmac_f32 v8, v39, v78
v_fmac_f32 v9, v39, v79
v_mul_f32 v8, v8, v13
v_mul_f32 v9, v9, v13
v_cvt_pk_bf16_f32 v8, v8, v9
s_lshl_b32 s73, s66, 8
s_mov_b32 s76, s58
s_mov_b32 s77, s59
s_mov_b32 s78, 0x4000
s_mov_b32 s79, 0x20000
v_lshrrev_b32 v26, 2, v26
buffer_store_dword v8, v26, s[76:79], s73 offen
L_dump:
L_end:
s_endpgm
.section .rodata,"a"
.p2align 6
.amdhsa_kernel standalone__kv_cache_quant_pre_rope_vs_post_rope__decode_kernel
.amdhsa_next_free_vgpr 256
.amdhsa_next_free_sgpr 102
.amdhsa_accum_offset 256
.amdhsa_group_segment_fixed_size 0
.amdhsa_kernarg_size 112
.amdhsa_user_sgpr_count 2
.amdhsa_user_sgpr_kernarg_segment_ptr 1
.amdhsa_system_sgpr_workgroup_id_x 1
.amdhsa_float_denorm_mode_32 3
.end_amdhsa_kernel
```
